```python
import torch

def _softmax(x, axis=-1):
    return torch.softmax(x, dim=axis)
def _gelu(x):
    return torch.nn.functional.gelu(x, approximate="tanh")
def _silu(x):
    return torch.nn.functional.silu(x)
def _sigmoid(x):
    return torch.sigmoid(x)
def _layernorm(x, axis=-1, eps=1e-5):
    m = x.mean(dim=axis, keepdim=True)
    v = x.var(dim=axis, keepdim=True, unbiased=False)
    return (x - m) / torch.sqrt(v + eps)
def _scatter_add(tgt, idx, src, axis=0):
    return tgt.clone().index_add_(axis, idx, src)
def _segment_sum(src, seg, n):
    out = torch.zeros((n,) + src.shape[1:], dtype=src.dtype)
    return out.index_add_(0, seg, src)
def _pad(x, pw):
    flat = tuple(v for pair in reversed(pw) for v in pair)
    return torch.nn.functional.pad(x, flat)

kernel_name = 'recurrent_scan__sliding_block_cached__glu_gated_reglu__decode'

def setup_inputs():

    _w = (lambda a: (lambda t: t.to(torch.bfloat16) if t.is_floating_point() else t)(torch.as_tensor(a)))
    def _A_setup():
        B, Sq, D = 1, 1, 640
        Hq, Hkv, Sk, Dh = 32, 32, 8192, 192
        assert Hq % Hkv == 0, (Hq, Hkv)
        return {
            "x": _w((lambda *s: torch.randn(*s, dtype=torch.bfloat16) * 0.05)(B, Sq, D)),
            "k_cache": _w((lambda *s: torch.randn(*s, dtype=torch.bfloat16) * 3.2)(B, Hkv, Sk, Dh)),
            "v_cache": _w((lambda *s: torch.randn(*s, dtype=torch.bfloat16) * 3.2)(B, Hkv, Sk, Dh)),
            "wq": _w((lambda *s: torch.randn(*s, dtype=torch.bfloat16) * 3.2)(D, Hq * Dh) * (D ** -0.5)),
            "wo": _w((lambda *s: torch.randn(*s, dtype=torch.bfloat16) * 3.2)(Hq * Dh, D) * ((Hq * Dh) ** -0.5)),
        }
    _A_in = _A_setup()

    def _B_setup():
        B, S, D, F = 1, 1, 640, 1536
        return {
            "x": _w((lambda *s: torch.randn(*s, dtype=torch.bfloat16) * 0.05)(B, S, D)),
            "W_gate": _w((lambda *s: torch.randn(*s, dtype=torch.bfloat16) * 0.4)(D, F) * (2.0 / D) ** 0.5),
            "W_up": _w((lambda *s: torch.randn(*s, dtype=torch.bfloat16) * 0.4)(D, F) * (2.0 / D) ** 0.5),
            "W_down": _w((lambda *s: torch.randn(*s, dtype=torch.bfloat16) * 0.4)(F, D) * (1.0 / F) ** 0.5),
        }
    _B_in = _B_setup()

    return {
        "A_x": _A_in["x"],
        "A_k_cache": _A_in["k_cache"],
        "A_v_cache": _A_in["v_cache"],
        "A_wq": _A_in["wq"],
        "A_wo": _A_in["wo"],
        "B_x": _B_in["x"],
        "B_W_gate": _B_in["W_gate"],
        "B_W_up": _B_in["W_up"],
        "B_W_down": _B_in["W_down"],
    }

def reference(A_x, A_k_cache, A_v_cache, A_wq, A_wo, B_x, B_W_gate, B_W_up, B_W_down):
    def _A_ref(x, k_cache, v_cache, wq, wo):
        B, Sq, D = x.shape
        Hq, Dh = 32, 192
        Hkv, Sk = k_cache.shape[1], k_cache.shape[2]
        W = min(4096, max(256, Sk // 4))
        rep = Hq // Hkv
        q = (lambda x, *d: x.permute(*d))((x @ wq).reshape(B, Sq, Hq, Dh), 0, 2, 1, 3)
        k = (lambda x, n, axis: torch.repeat_interleave(x, n, dim=axis))(k_cache[:, :, Sk - W:, :], rep, axis=1)
        v = (lambda x, n, axis: torch.repeat_interleave(x, n, dim=axis))(v_cache[:, :, Sk - W:, :], rep, axis=1)
        scores = torch.einsum("bhqd,bhkd->bhqk", q, k) * (Dh ** -0.5)
        p = _softmax(scores, axis=-1)
        o = torch.einsum("bhqk,bhkd->bhqd", p, v)
        return (lambda x, *d: x.permute(*d))(o, 0, 2, 1, 3).reshape(B, Sq, Hq * Dh) @ wo

    def _B_ref(x, W_gate, W_up, W_down):
        gate = torch.einsum("bsd,df->bsf", x, W_gate)
        up = torch.einsum("bsd,df->bsf", x, W_up)
        gate = gate * (lambda x, dt: x.to(dt))(gate > 0, gate.dtype)
        h = gate * up
        return torch.einsum("bsf,fd->bsd", h, W_down)

    x = A_x
    xn = _layernorm(x, axis=-1)
    s = _A_ref(xn, A_k_cache, A_v_cache, A_wq, A_wo)
    g = _silu(_B_ref(xn, B_W_gate, B_W_up, B_W_down))
    return x + s * g
```

```asm
; @launch grid=(256,1,1) block=(512,1,1) lds=18432
.amdgcn_target "amdgcn-amd-amdhsa--gfx950"
.text
.globl recurrent_scan__sliding_block_cached__glu_gated_reglu__decode_kernel
.p2align 8
.type recurrent_scan__sliding_block_cached__glu_gated_reglu__decode_kernel,@function
recurrent_scan__sliding_block_cached__glu_gated_reglu__decode_kernel:
    s_cmp_ge_u32 s2, 256
    s_cbranch_scc1 L_end
    s_load_dwordx16 s[8:23], s[0:1], 0
    s_load_dwordx8 s[24:31], s[0:1], 64
    v_lshrrev_b32 v1, 6, v0
    v_and_b32 v0, 63, v0
    v_readfirstlane_b32 s3, v1
    s_and_b32 s6, s2, 7
    s_lshr_b32 s7, s2, 3
    s_and_b32 s4, s7, 3
    s_lshl_b32 s5, s6, 2
    s_add_u32 s4, s4, s5
    s_lshr_b32 s5, s7, 2
    s_mul_i32 s74, s6, 30
    s_add_u32 s74, s74, s7
    s_lshl_b32 s75, s4, 3
    s_add_u32 s75, s75, s5
    s_mul_i32 s6, s74, 205
    s_lshr_b32 s32, s6, 11
    s_lshr_b32 s33, s6, 10
    s_mul_i32 s34, s32, 10
    s_sub_u32 s34, s74, s34
    s_mul_i32 s35, s33, 5
    s_sub_u32 s35, s74, s35
    v_lshrrev_b32 v1, 3, v0
    v_and_b32 v2, 7, v0
    s_mov_b32 s60, 0xffff0000
    s_cmp_ge_u32 s3, 4
    s_cbranch_scc1 L_kv
    s_getpc_b64 s[36:37]
L_pc:
    v_mov_b32 v5, 0
    s_lshl_b32 s6, s3, 2
    v_mov_b32 v3, s6
    ds_write_b32 v3, v5 offset:13344
    v_lshlrev_b32 v3, 2, v0
    s_cmp_eq_u32 s3, 3
    s_cbranch_scc1 L_w3
    s_mul_i32 s6, s5, 3
    s_add_u32 s6, s6, s3
    s_and_b32 s61, s6, 7
    s_lshr_b32 s6, s6, 3
    s_lshl_b32 s6, s6, 7
    s_mul_i32 s7, s4, 384
    s_add_u32 s6, s6, s7
    s_mul_i32 s7, s61, 983040
    s_add_u32 s6, s6, s7
    s_mul_i32 s63, s61, 320
    v_mul_u32_u24 v8, 12288, v1
    v_lshl_add_u32 v8, v2, 4, v8
    s_mov_b32 s62, 98304
    s_mov_b32 s61, 98304
    s_mov_b32 s42, 970880
    s_mov_b32 s43, 0x20000
    s_mov_b32 s54, 1280
    s_mov_b32 s55, 0x20000
    s_waitcnt lgkmcnt(0)
    s_mov_b32 s52, s8
    s_mov_b32 s53, s9
    s_add_u32 s40, s14, s6
    s_addc_u32 s41, s15, 0
    buffer_load_dword v10, v3, s[52:55], 0 offen offset:0
    buffer_load_dword v11, v3, s[52:55], 0 offen offset:256
    buffer_load_dword v12, v3, s[52:55], 0 offen offset:512
    buffer_load_dword v13, v3, s[52:55], 0 offen offset:768
    buffer_load_dword v14, v3, s[52:55], 0 offen offset:1024
    buffer_load_dwordx4 v[64:67], v8, s[40:43], 0 offen nt
    buffer_load_dwordx4 v[68:71], v8, s[40:43], s61 offen nt
    s_add_u32 s61, s61, s62
    buffer_load_dwordx4 v[72:75], v8, s[40:43], s61 offen nt
    s_add_u32 s61, s61, s62
    buffer_load_dwordx4 v[76:79], v8, s[40:43], s61 offen nt
    s_add_u32 s61, s61, s62
    buffer_load_dwordx4 v[80:83], v8, s[40:43], s61 offen nt
    s_add_u32 s61, s61, s62
    buffer_load_dwordx4 v[84:87], v8, s[40:43], s61 offen nt
    s_add_u32 s61, s61, s62
    buffer_load_dwordx4 v[88:91], v8, s[40:43], s61 offen nt
    s_add_u32 s61, s61, s62
    buffer_load_dwordx4 v[92:95], v8, s[40:43], s61 offen nt
    s_add_u32 s61, s61, s62
    buffer_load_dwordx4 v[96:99], v8, s[40:43], s61 offen nt
    s_add_u32 s61, s61, s62
    buffer_load_dwordx4 v[100:103], v8, s[40:43], s61 offen nt
    s_lshl_b32 s6, s3, 6
    v_add_u32 v4, s6, v0
    v_min_u32 v4, 69, v4
    v_lshl_add_u64 v[6:7], v[4:5], 7, s[36:37]
    global_load_dword v61, v[6:7], off
    s_barrier
    s_load_dword s39, s[30:31], 0
    s_mov_b32 s48, s30
    s_mov_b32 s49, s31
    s_mov_b32 s50, 4194304
    s_mov_b32 s51, 0x20000
    s_add_u32 s56, s30, 0x280000
    s_addc_u32 s57, s31, 0
    s_mov_b32 s58, 0x180000
    s_mov_b32 s59, 0x20000
    s_waitcnt vmcnt(11)
    s_branch L_ln
L_w3:
    s_cmp_ge_u32 s2, 240
    s_cbranch_scc1 L_w3_skip
    s_cmp_ge_u32 s34, 5
    s_cselect_b32 s61, 5, 0
    s_sub_u32 s61, s34, s61
    s_lshl_b32 s63, s61, 9
    s_mul_i32 s61, s61, 393216
    s_lshl_b32 s62, s32, 7
    s_add_u32 s67, s61, s62
    s_mov_b32 s42, 390272
    s_mov_b32 s43, 0x20000
    v_mul_u32_u24 v8, 3072, v1
    v_lshl_add_u32 v8, v2, 4, v8
    s_mov_b32 s62, 24576
    s_mov_b32 s61, 24576
    s_mov_b32 s54, 1280
    s_mov_b32 s55, 0x20000
    s_cmp_ge_u32 s34, 5
    s_waitcnt lgkmcnt(0)
    s_cselect_b32 s6, s22, s20
    s_cselect_b32 s7, s23, s21
    s_mov_b32 s52, s8
    s_mov_b32 s53, s9
    s_add_u32 s40, s6, s67
    s_addc_u32 s41, s7, 0
    buffer_load_dword v10, v3, s[52:55], 0 offen offset:0
    buffer_load_dword v11, v3, s[52:55], 0 offen offset:256
    buffer_load_dword v12, v3, s[52:55], 0 offen offset:512
    buffer_load_dword v13, v3, s[52:55], 0 offen offset:768
    buffer_load_dword v14, v3, s[52:55], 0 offen offset:1024
    buffer_load_dwordx4 v[64:67], v8, s[40:43], 0 offen nt
    buffer_load_dwordx4 v[68:71], v8, s[40:43], s61 offen nt
    s_add_u32 s61, s61, s62
    buffer_load_dwordx4 v[72:75], v8, s[40:43], s61 offen nt
    s_add_u32 s61, s61, s62
    buffer_load_dwordx4 v[76:79], v8, s[40:43], s61 offen nt
    s_add_u32 s61, s61, s62
    buffer_load_dwordx4 v[80:83], v8, s[40:43], s61 offen nt
    s_add_u32 s61, s61, s62
    buffer_load_dwordx4 v[84:87], v8, s[40:43], s61 offen nt
    s_add_u32 s61, s61, s62
    buffer_load_dwordx4 v[88:91], v8, s[40:43], s61 offen nt
    s_add_u32 s61, s61, s62
    buffer_load_dwordx4 v[92:95], v8, s[40:43], s61 offen nt
    s_add_u32 s61, s61, s62
    buffer_load_dwordx4 v[96:99], v8, s[40:43], s61 offen nt
    s_add_u32 s61, s61, s62
    buffer_load_dwordx4 v[100:103], v8, s[40:43], s61 offen nt
    s_add_u32 s61, s61, s62
    buffer_load_dwordx4 v[104:107], v8, s[40:43], s61 offen nt
    s_add_u32 s61, s61, s62
    buffer_load_dwordx4 v[108:111], v8, s[40:43], s61 offen nt
    s_add_u32 s61, s61, s62
    buffer_load_dwordx4 v[112:115], v8, s[40:43], s61 offen nt
    s_add_u32 s61, s61, s62
    buffer_load_dwordx4 v[116:119], v8, s[40:43], s61 offen nt
    s_add_u32 s61, s61, s62
    buffer_load_dwordx4 v[120:123], v8, s[40:43], s61 offen nt
    s_add_u32 s61, s61, s62
    buffer_load_dwordx4 v[124:127], v8, s[40:43], s61 offen nt
    s_barrier
    s_load_dword s39, s[30:31], 0
    s_mov_b32 s48, s30
    s_mov_b32 s49, s31
    s_mov_b32 s50, 4194304
    s_mov_b32 s51, 0x20000
    s_add_u32 s56, s30, 0x280000
    s_addc_u32 s57, s31, 0
    s_mov_b32 s58, 0x180000
    s_mov_b32 s59, 0x20000
    s_waitcnt vmcnt(16)
L_ln:
    v_and_b32 v9, 3, v2
    v_lshlrev_b32 v9, 4, v9
    v_mov_b32 v4, 0xffff
    v_mov_b32 v5, 0
    v_lshlrev_b64 v[26:27], v9, v[4:5]
    v_lshrrev_b32 v9, 2, v2
    v_add_u32 v9, -1, v9
    v_and_b32 v4, v26, v9
    v_and_b32 v5, v27, v9
    v_not_b32 v9, v9
    v_and_b32 v6, v26, v9
    v_and_b32 v7, v27, v9
    v_lshlrev_b32 v15, 16, v10
    v_and_b32 v16, s60, v10
    v_lshlrev_b32 v17, 16, v11
    v_and_b32 v18, s60, v11
    v_lshlrev_b32 v19, 16, v12
    v_and_b32 v20, s60, v12
    v_lshlrev_b32 v21, 16, v13
    v_and_b32 v22, s60, v13
    v_lshlrev_b32 v23, 16, v14
    v_and_b32 v24, s60, v14
    v_mov_b32 v30, 0x3acccccd
    v_add_f32 v25, v15, v16
    v_add_f32 v26, v17, v18
    v_add_f32 v27, v19, v20
    v_add_f32 v28, v21, v22
    v_add_f32 v29, v23, v24
    v_add_f32 v25, v25, v26
    v_add_f32 v27, v27, v28
    v_add_f32 v25, v25, v29
    v_add_f32 v25, v25, v27
    s_nop 1
    v_add_f32_dpp v25, v25, v25 quad_perm:[1,0,3,2] row_mask:0xf bank_mask:0xf
    s_nop 1
    v_add_f32_dpp v25, v25, v25 quad_perm:[2,3,0,1] row_mask:0xf bank_mask:0xf
    s_nop 1
    v_add_f32_dpp v25, v25, v25 row_half_mirror row_mask:0xf bank_mask:0xf
    s_nop 1
    v_add_f32_dpp v25, v25, v25 row_mirror row_mask:0xf bank_mask:0xf
    s_nop 1
    v_add_f32_dpp v25, v25, v25 row_bcast:15 row_mask:0xa bank_mask:0xf
    s_nop 1
    v_add_f32_dpp v25, v25, v25 row_bcast:31 row_mask:0xc bank_mask:0xf
    s_nop 0
    v_readlane_b32 s67, v25, 63
    s_nop 1
    v_mul_f32 v26, s67, v30
    v_sub_f32 v32, v15, v26
    v_sub_f32 v33, v16, v26
    v_sub_f32 v34, v17, v26
    v_sub_f32 v35, v18, v26
    v_sub_f32 v36, v19, v26
    v_sub_f32 v37, v20, v26
    v_sub_f32 v38, v21, v26
    v_sub_f32 v39, v22, v26
    v_sub_f32 v40, v23, v26
    v_sub_f32 v41, v24, v26
    v_mul_f32 v27, v32, v32
    v_mul_f32 v28, v33, v33
    v_fmac_f32 v27, v34, v34
    v_fmac_f32 v28, v35, v35
    v_fmac_f32 v27, v36, v36
    v_fmac_f32 v28, v37, v37
    v_fmac_f32 v27, v38, v38
    v_fmac_f32 v28, v39, v39
    v_fmac_f32 v27, v40, v40
    v_fmac_f32 v28, v41, v41
    v_add_f32 v27, v27, v28
    s_nop 1
    v_add_f32_dpp v27, v27, v27 quad_perm:[1,0,3,2] row_mask:0xf bank_mask:0xf
    s_nop 1
    v_add_f32_dpp v27, v27, v27 quad_perm:[2,3,0,1] row_mask:0xf bank_mask:0xf
    s_nop 1
    v_add_f32_dpp v27, v27, v27 row_half_mirror row_mask:0xf bank_mask:0xf
    s_nop 1
    v_add_f32_dpp v27, v27, v27 row_mirror row_mask:0xf bank_mask:0xf
    s_nop 1
    v_add_f32_dpp v27, v27, v27 row_bcast:15 row_mask:0xa bank_mask:0xf
    s_nop 1
    v_add_f32_dpp v27, v27, v27 row_bcast:31 row_mask:0xc bank_mask:0xf
    s_nop 0
    v_readlane_b32 s68, v27, 63
    s_nop 1
    v_mul_f32 v27, s68, v30
    v_cvt_pk_bf16_f32 v28, v27, v26
    v_lshlrev_b32 v29, 16, v28
    v_and_b32 v26, s60, v28
    v_add_f32 v29, 0x3727c5ac, v29
    v_cvt_pk_bf16_f32 v29, v29, v29
    v_lshlrev_b32 v29, 16, v29
    v_sqrt_f32 v29, v29
    s_nop 0
    v_cvt_pk_bf16_f32 v29, v29, v29
    v_lshlrev_b32 v29, 16, v29
    v_rcp_f32 v28, v29
    v_sub_f32 v32, v15, v26
    v_sub_f32 v33, v16, v26
    v_sub_f32 v34, v17, v26
    v_sub_f32 v35, v18, v26
    v_sub_f32 v36, v19, v26
    v_sub_f32 v37, v20, v26
    v_sub_f32 v38, v21, v26
    v_sub_f32 v39, v22, v26
    v_sub_f32 v40, v23, v26
    v_sub_f32 v41, v24, v26
    v_cvt_pk_bf16_f32 v10, v32, v33
    v_cvt_pk_bf16_f32 v11, v34, v35
    v_cvt_pk_bf16_f32 v12, v36, v37
    v_cvt_pk_bf16_f32 v13, v38, v39
    v_cvt_pk_bf16_f32 v14, v40, v41
    v_lshlrev_b32 v32, 16, v10
    v_and_b32 v33, s60, v10
    v_lshlrev_b32 v34, 16, v11
    v_and_b32 v35, s60, v11
    v_lshlrev_b32 v36, 16, v12
    v_and_b32 v37, s60, v12
    v_lshlrev_b32 v38, 16, v13
    v_and_b32 v39, s60, v13
    v_lshlrev_b32 v40, 16, v14
    v_and_b32 v41, s60, v14
    v_mul_f32 v42, v32, v28
    v_mul_f32 v43, v33, v28
    v_mul_f32 v44, v34, v28
    v_mul_f32 v45, v35, v28
    v_mul_f32 v46, v36, v28
    v_mul_f32 v47, v37, v28
    v_mul_f32 v48, v38, v28
    v_mul_f32 v49, v39, v28
    v_mul_f32 v50, v40, v28
    v_mul_f32 v51, v41, v28
    v_fma_f32 v32, -v42, v29, v32
    v_fma_f32 v33, -v43, v29, v33
    v_fma_f32 v34, -v44, v29, v34
    v_fma_f32 v35, -v45, v29, v35
    v_fma_f32 v36, -v46, v29, v36
    v_fma_f32 v37, -v47, v29, v37
    v_fma_f32 v38, -v48, v29, v38
    v_fma_f32 v39, -v49, v29, v39
    v_fma_f32 v40, -v50, v29, v40
    v_fma_f32 v41, -v51, v29, v41
    v_fmac_f32 v42, v32, v28
    v_fmac_f32 v43, v33, v28
    v_fmac_f32 v44, v34, v28
    v_fmac_f32 v45, v35, v28
    v_fmac_f32 v46, v36, v28
    v_fmac_f32 v47, v37, v28
    v_fmac_f32 v48, v38, v28
    v_fmac_f32 v49, v39, v28
    v_fmac_f32 v50, v40, v28
    v_fmac_f32 v51, v41, v28
    v_cvt_pk_bf16_f32 v32, v42, v42
    v_cvt_pk_bf16_f32 v33, v43, v43
    v_cvt_pk_bf16_f32 v34, v44, v44
    v_cvt_pk_bf16_f32 v35, v45, v45
    v_cvt_pk_bf16_f32 v36, v46, v46
    v_cvt_pk_bf16_f32 v37, v47, v47
    v_cvt_pk_bf16_f32 v38, v48, v48
    v_cvt_pk_bf16_f32 v39, v49, v49
    v_cvt_pk_bf16_f32 v40, v50, v50
    v_cvt_pk_bf16_f32 v41, v51, v51
    v_lshlrev_b32 v3, 3, v0
    ds_write_b64 v3, v[32:33] offset:0
    ds_write_b64 v3, v[34:35] offset:512
    ds_write_b64 v3, v[36:37] offset:1024
    ds_write_b64 v3, v[38:39] offset:1536
    ds_write_b64 v3, v[40:41] offset:2048
    v_lshrrev_b32 v9, 5, v0
    v_lshlrev_b32 v9, 8, v9
    v_lshl_add_u32 v9, v2, 5, v9
    v_bfe_u32 v3, v0, 4, 1
    v_lshl_add_u32 v56, v3, 4, v9
    s_lshl_b32 s6, s3, 10
    s_add_u32 s6, s6, 2560
    v_add_u32 v56, s6, v56
    v_lshl_add_u32 v57, v0, 2, s6
    v_lshl_add_u32 v3, v1, 2, s63
    v_lshlrev_b32 v58, 3, v0
    s_mov_b32 s64, 0x00ff00ff
    s_mov_b32 s65, 0xff00ff00
    s_cmp_eq_u32 s3, 3
    s_cbranch_scc1 L_w3b
    ds_read_b32 v42, v3 offset:0
    ds_read_b32 v43, v3 offset:32
    ds_read_b32 v44, v3 offset:64
    ds_read_b32 v45, v3 offset:96
    ds_read_b32 v46, v3 offset:128
    ds_read_b32 v47, v3 offset:160
    ds_read_b32 v48, v3 offset:192
    ds_read_b32 v49, v3 offset:224
    ds_read_b32 v50, v3 offset:256
    ds_read_b32 v51, v3 offset:288
    s_waitcnt lgkmcnt(0)
    s_mul_i32 s38, s39, 0x9e3779b1
    s_xor_b32 s38, s38, 0x7f4a7c15
    v_and_b32 v128, v42, v4
    v_and_b32 v129, v42, v5
    v_and_b32 v130, v42, v6
    v_and_b32 v131, v42, v7
    v_and_b32 v132, v43, v4
    v_and_b32 v133, v43, v5
    v_and_b32 v134, v43, v6
    v_and_b32 v135, v43, v7
    v_and_b32 v136, v44, v4
    v_and_b32 v137, v44, v5
    v_and_b32 v138, v44, v6
    v_and_b32 v139, v44, v7
    v_and_b32 v140, v45, v4
    v_and_b32 v141, v45, v5
    v_and_b32 v142, v45, v6
    v_and_b32 v143, v45, v7
    v_and_b32 v144, v46, v4
    v_and_b32 v145, v46, v5
    v_and_b32 v146, v46, v6
    v_and_b32 v147, v46, v7
    v_and_b32 v148, v47, v4
    v_and_b32 v149, v47, v5
    v_and_b32 v150, v47, v6
    v_and_b32 v151, v47, v7
    v_and_b32 v152, v48, v4
    v_and_b32 v153, v48, v5
    v_and_b32 v154, v48, v6
    v_and_b32 v155, v48, v7
    v_and_b32 v156, v49, v4
    v_and_b32 v157, v49, v5
    v_and_b32 v158, v49, v6
    v_and_b32 v159, v49, v7
    v_and_b32 v160, v50, v4
    v_and_b32 v161, v50, v5
    v_and_b32 v162, v50, v6
    v_and_b32 v163, v50, v7
    v_and_b32 v164, v51, v4
    v_and_b32 v165, v51, v5
    v_and_b32 v166, v51, v6
    v_and_b32 v167, v51, v7
    s_waitcnt vmcnt(10)
    v_mfma_f32_16x16x32_bf16 v[192:195], v[128:131], v[64:67], 0
    s_waitcnt vmcnt(9)
    v_mfma_f32_16x16x32_bf16 v[192:195], v[132:135], v[68:71], v[192:195]
    s_waitcnt vmcnt(8)
    v_mfma_f32_16x16x32_bf16 v[192:195], v[136:139], v[72:75], v[192:195]
    s_waitcnt vmcnt(7)
    v_mfma_f32_16x16x32_bf16 v[192:195], v[140:143], v[76:79], v[192:195]
    s_waitcnt vmcnt(6)
    v_mfma_f32_16x16x32_bf16 v[192:195], v[144:147], v[80:83], v[192:195]
    s_waitcnt vmcnt(5)
    v_mfma_f32_16x16x32_bf16 v[192:195], v[148:151], v[84:87], v[192:195]
    s_waitcnt vmcnt(4)
    v_mfma_f32_16x16x32_bf16 v[192:195], v[152:155], v[88:91], v[192:195]
    s_waitcnt vmcnt(3)
    v_mfma_f32_16x16x32_bf16 v[192:195], v[156:159], v[92:95], v[192:195]
    s_waitcnt vmcnt(2)
    v_mfma_f32_16x16x32_bf16 v[192:195], v[160:163], v[96:99], v[192:195]
    s_waitcnt vmcnt(1)
    v_mfma_f32_16x16x32_bf16 v[192:195], v[164:167], v[100:103], v[192:195]
    s_lshl_b32 s6, s3, 2
    v_mov_b32 v9, s6
    v_mov_b32 v10, 1
    s_mov_b64 exec, s[64:65]
    s_nop 4
    ds_write_b128 v56, v[192:195]
    s_mov_b64 exec, -1
    s_cmp_eq_u32 s3, 2
    s_cbranch_scc1 L_q2
    s_waitcnt lgkmcnt(0)
    ds_write_b32 v9, v10 offset:13344
    s_branch L_bar1
L_q2:
    v_lshlrev_b32 v57, 2, v0
    v_mov_b32 v9, 0
    s_add_u32 s6, s5, 0
    s_cmp_ge_u32 s5, 3
    s_addc_u32 s6, s6, 0
    s_cmp_ge_u32 s5, 6
    s_addc_u32 s6, s6, 0
    s_mul_i32 s69, s4, 10
    s_add_u32 s6, s6, s69
    s_lshl_b32 s6, s6, 9
    s_add_u32 s6, s6, 4096
    s_lshl_b32 s69, s69, 9
    s_add_u32 s69, s69, 4096
    s_add_u32 s70, s69, 4096
    s_mov_b32 s66, 32768
L_lspin:
    ds_read_b64 v[10:11], v9 offset:13344
    s_waitcnt lgkmcnt(0)
    v_and_b32 v10, v10, v11
    s_sub_u32 s66, s66, 1
    s_cbranch_scc1 L_exit
    v_readfirstlane_b32 s7, v10
    s_nop 0
    s_cmp_eq_u32 s7, 1
    s_cbranch_scc0 L_lspin
    ds_read2st64_b32 v[44:45], v57 offset0:10 offset1:11
    ds_read2st64_b32 v[46:47], v57 offset0:14 offset1:15
    ds_read2st64_b32 v[48:49], v57 offset0:18 offset1:19
    v_mov_b32 v53, s38
    s_waitcnt lgkmcnt(0)
    v_add_f32 v44, v44, v45
    v_add_f32 v46, v46, v47
    v_add_f32 v48, v48, v49
    s_cmp_eq_u32 s5, 2
    s_cbranch_scc1 L_qc2
    s_cmp_eq_u32 s5, 5
    s_cbranch_scc1 L_qc5
    v_add_f32 v52, v44, v46
    v_add_f32 v52, v52, v48
    buffer_store_dwordx2 v[52:53], v58, s[48:51], s6 offen
    s_mov_b32 s61, 0
    s_branch L_qpub
L_qc2:
    v_add_f32 v52, v44, v46
    v_mov_b32 v50, v48
    s_branch L_qtwo
L_qc5:
    v_mov_b32 v52, v44
    v_add_f32 v50, v46, v48
L_qtwo:
    v_mov_b32 v51, s38
    buffer_store_dwordx2 v[52:53], v58, s[48:51], s6 offen
    buffer_store_dwordx2 v[50:51], v58, s[48:51], s6 offen offset:512
    s_mov_b32 s61, 1
L_qpub:
    s_mov_b32 s62, s6
    s_and_b32 s6, s2, 7
    s_lshl_b32 s6, s6, 8
    s_add_u32 s6, s6, 1024
    v_and_b32 v60, 31, v0
    v_lshlrev_b32 v60, 3, v60
    buffer_load_dwordx2 v[62:63], v60, s[48:51], s6 offen sc1
    s_mov_b32 s68, 0x280000
    s_mov_b32 s66, 32768
L_qspin:
    buffer_load_dwordx2 v[64:65], v58, s[48:51], s69 offen offset:0 sc1
    buffer_load_dwordx2 v[66:67], v58, s[48:51], s69 offen offset:512 sc1
    buffer_load_dwordx2 v[68:69], v58, s[48:51], s69 offen offset:1024 sc1
    buffer_load_dwordx2 v[70:71], v58, s[48:51], s69 offen offset:1536 sc1
    buffer_load_dwordx2 v[72:73], v58, s[48:51], s69 offen offset:2048 sc1
    buffer_load_dwordx2 v[74:75], v58, s[48:51], s69 offen offset:2560 sc1
    buffer_load_dwordx2 v[76:77], v58, s[48:51], s69 offen offset:3072 sc1
    buffer_load_dwordx2 v[78:79], v58, s[48:51], s69 offen offset:3584 sc1
    buffer_load_dwordx2 v[80:81], v58, s[48:51], s70 offen offset:0 sc1
    buffer_load_dwordx2 v[82:83], v58, s[48:51], s70 offen offset:512 sc1
    s_waitcnt vmcnt(0)
    s_cmp_lg_u32 s66, 32768
    s_cbranch_scc1 L_qmode
    s_getreg_b32 s36, hwreg(HW_REG_XCC_ID, 0, 4)
    v_cmp_eq_u32 vcc, s38, v63
    v_cmp_eq_u32 s[72:73], s36, v62
    s_nop 0
    s_and_b64 vcc, vcc, s[72:73]
    s_cmp_eq_u64 vcc, -1
    s_cselect_b32 s37, 1, 0
    v_mov_b32 v9, s37
    v_mov_b32 v10, 13376
    ds_write_b32 v10, v9
    s_cmp_eq_u32 s37, 1
    s_cselect_b32 s71, 32, 3
    s_sub_u32 s71, 32768, s71
    s_cmp_eq_u32 s37, 1
    s_cbranch_scc1 L_qmode
    buffer_store_dwordx2 v[52:53], v58, s[56:59], s62 offen sc1
    s_cmp_eq_u32 s61, 1
    s_cbranch_scc0 L_qmode
    buffer_store_dwordx2 v[50:51], v58, s[56:59], s62 offen offset:512 sc1
L_qmode:
    v_min3_u32 v54, v65, v67, v69
    v_min3_u32 v54, v54, v71, v73
    v_min3_u32 v54, v54, v75, v77
    v_min3_u32 v54, v54, v79, v81
    v_min_u32 v54, v54, v83
    v_max3_u32 v55, v65, v67, v69
    v_max3_u32 v55, v55, v71, v73
    v_max3_u32 v55, v55, v75, v77
    v_max3_u32 v55, v55, v79, v81
    v_max_u32 v55, v55, v83
    v_cmp_ne_u32 vcc, s38, v54
    v_cmp_ne_u32 s[72:73], s38, v55
    s_sub_u32 s66, s66, 1
    s_cbranch_scc1 L_exit
    s_cmp_gt_u32 s66, s71
    s_cbranch_scc1 L_qspin_k
    s_add_u32 s69, s69, s68
    s_add_u32 s70, s70, s68
    s_sub_u32 s68, 0, s68
L_qspin_k:
    s_or_b64 vcc, vcc, s[72:73]
    s_cbranch_vccnz L_qspin
    v_add_f32 v52, v64, v66
    v_add_f32 v53, v70, v72
    v_add_f32 v54, v78, v80
    v_add_f32 v52, v52, v68
    v_add_f32 v53, v53, v74
    v_add_f32 v54, v54, v82
    v_add_f32 v53, v53, v76
    v_lshlrev_b32 v3, 1, v0
    v_cvt_pk_bf16_f32 v52, v52, v53
    v_cvt_pk_bf16_f32 v54, v54, v54
    ds_write_b16 v3, v52 offset:6656
    ds_write_b16_d16_hi v3, v52 offset:6784
    ds_write_b16 v3, v54 offset:6912
    s_branch L_bar1
L_w3b:
    ds_read_b32 v32, v3 offset:0
    ds_read_b32 v33, v3 offset:32
    ds_read_b32 v34, v3 offset:64
    ds_read_b32 v35, v3 offset:96
    ds_read_b32 v36, v3 offset:128
    ds_read_b32 v37, v3 offset:160
    ds_read_b32 v38, v3 offset:192
    ds_read_b32 v39, v3 offset:224
    ds_read_b32 v40, v3 offset:256
    ds_read_b32 v41, v3 offset:288
    ds_read_b32 v42, v3 offset:320
    ds_read_b32 v43, v3 offset:352
    ds_read_b32 v44, v3 offset:384
    ds_read_b32 v45, v3 offset:416
    ds_read_b32 v46, v3 offset:448
    ds_read_b32 v47, v3 offset:480
    s_waitcnt lgkmcnt(0)
    s_mul_i32 s38, s39, 0x9e3779b1
    s_xor_b32 s38, s38, 0x7f4a7c15
    v_and_b32 v128, v32, v4
    v_and_b32 v129, v32, v5
    v_and_b32 v130, v32, v6
    v_and_b32 v131, v32, v7
    v_and_b32 v132, v33, v4
    v_and_b32 v133, v33, v5
    v_and_b32 v134, v33, v6
    v_and_b32 v135, v33, v7
    v_and_b32 v136, v34, v4
    v_and_b32 v137, v34, v5
    v_and_b32 v138, v34, v6
    v_and_b32 v139, v34, v7
    v_and_b32 v140, v35, v4
    v_and_b32 v141, v35, v5
    v_and_b32 v142, v35, v6
    v_and_b32 v143, v35, v7
    v_and_b32 v144, v36, v4
    v_and_b32 v145, v36, v5
    v_and_b32 v146, v36, v6
    v_and_b32 v147, v36, v7
    v_and_b32 v148, v37, v4
    v_and_b32 v149, v37, v5
    v_and_b32 v150, v37, v6
    v_and_b32 v151, v37, v7
    v_and_b32 v152, v38, v4
    v_and_b32 v153, v38, v5
    v_and_b32 v154, v38, v6
    v_and_b32 v155, v38, v7
    v_and_b32 v156, v39, v4
    v_and_b32 v157, v39, v5
    v_and_b32 v158, v39, v6
    v_and_b32 v159, v39, v7
    v_and_b32 v160, v40, v4
    v_and_b32 v161, v40, v5
    v_and_b32 v162, v40, v6
    v_and_b32 v163, v40, v7
    v_and_b32 v164, v41, v4
    v_and_b32 v165, v41, v5
    v_and_b32 v166, v41, v6
    v_and_b32 v167, v41, v7
    v_and_b32 v168, v42, v4
    v_and_b32 v169, v42, v5
    v_and_b32 v170, v42, v6
    v_and_b32 v171, v42, v7
    v_and_b32 v172, v43, v4
    v_and_b32 v173, v43, v5
    v_and_b32 v174, v43, v6
    v_and_b32 v175, v43, v7
    v_and_b32 v176, v44, v4
    v_and_b32 v177, v44, v5
    v_and_b32 v178, v44, v6
    v_and_b32 v179, v44, v7
    v_and_b32 v180, v45, v4
    v_and_b32 v181, v45, v5
    v_and_b32 v182, v45, v6
    v_and_b32 v183, v45, v7
    v_and_b32 v184, v46, v4
    v_and_b32 v185, v46, v5
    v_and_b32 v186, v46, v6
    v_and_b32 v187, v46, v7
    v_and_b32 v188, v47, v4
    v_and_b32 v189, v47, v5
    v_and_b32 v190, v47, v6
    v_and_b32 v191, v47, v7
    s_waitcnt vmcnt(15)
    v_mfma_f32_16x16x32_bf16 v[192:195], v[128:131], v[64:67], 0
    s_waitcnt vmcnt(14)
    v_mfma_f32_16x16x32_bf16 v[192:195], v[132:135], v[68:71], v[192:195]
    s_waitcnt vmcnt(13)
    v_mfma_f32_16x16x32_bf16 v[192:195], v[136:139], v[72:75], v[192:195]
    s_waitcnt vmcnt(12)
    v_mfma_f32_16x16x32_bf16 v[192:195], v[140:143], v[76:79], v[192:195]
    s_waitcnt vmcnt(11)
    v_mfma_f32_16x16x32_bf16 v[192:195], v[144:147], v[80:83], v[192:195]
    s_waitcnt vmcnt(10)
    v_mfma_f32_16x16x32_bf16 v[192:195], v[148:151], v[84:87], v[192:195]
    s_waitcnt vmcnt(9)
    v_mfma_f32_16x16x32_bf16 v[192:195], v[152:155], v[88:91], v[192:195]
    s_waitcnt vmcnt(8)
    v_mfma_f32_16x16x32_bf16 v[192:195], v[156:159], v[92:95], v[192:195]
    s_waitcnt vmcnt(7)
    v_mfma_f32_16x16x32_bf16 v[192:195], v[160:163], v[96:99], v[192:195]
    s_waitcnt vmcnt(6)
    v_mfma_f32_16x16x32_bf16 v[192:195], v[164:167], v[100:103], v[192:195]
    s_waitcnt vmcnt(5)
    v_mfma_f32_16x16x32_bf16 v[192:195], v[168:171], v[104:107], v[192:195]
    s_waitcnt vmcnt(4)
    v_mfma_f32_16x16x32_bf16 v[192:195], v[172:175], v[108:111], v[192:195]
    s_waitcnt vmcnt(3)
    v_mfma_f32_16x16x32_bf16 v[192:195], v[176:179], v[112:115], v[192:195]
    s_waitcnt vmcnt(2)
    v_mfma_f32_16x16x32_bf16 v[192:195], v[180:183], v[116:119], v[192:195]
    s_waitcnt vmcnt(1)
    v_mfma_f32_16x16x32_bf16 v[192:195], v[184:187], v[120:123], v[192:195]
    s_waitcnt vmcnt(0)
    v_mfma_f32_16x16x32_bf16 v[192:195], v[188:191], v[124:127], v[192:195]
    s_lshl_b32 s6, s74, 9
    s_add_u32 s6, s6, 262144
    s_mul_i32 s69, s32, 5120
    s_and_b32 s7, s33, 1
    s_lshl_b32 s7, s7, 8
    s_add_u32 s69, s69, s7
    s_add_u32 s69, s69, 262144
    s_mov_b64 exec, s[64:65]
    s_nop 1
    ds_write_b128 v56, v[192:195]
    s_mov_b64 exec, -1
    ds_read2st64_b32 v[52:53], v57 offset0:0 offset1:1
    v_lshrrev_b32 v59, 5, v0
    v_mul_u32_u24 v59, 2560, v59
    v_and_b32 v3, 31, v0
    v_lshl_add_u32 v59, v3, 3, v59
    s_waitcnt lgkmcnt(0)
    v_add_f32 v52, v52, v53
    v_mov_b32 v53, s38
    buffer_store_dwordx2 v[52:53], v58, s[48:51], s6 offen
    s_mov_b32 s62, s6
    s_and_b32 s6, s2, 7
    s_lshl_b32 s6, s6, 8
    s_add_u32 s6, s6, 1024
    v_and_b32 v60, 31, v0
    v_lshlrev_b32 v60, 3, v60
    buffer_load_dwordx2 v[62:63], v60, s[48:51], s6 offen sc1
    s_mov_b32 s68, 0x280000
    s_mov_b32 s66, 32768
L_gspin:
    buffer_load_dwordx2 v[64:65], v59, s[48:51], s69 offen offset:0 sc1
    buffer_load_dwordx2 v[66:67], v59, s[48:51], s69 offen offset:512 sc1
    buffer_load_dwordx2 v[68:69], v59, s[48:51], s69 offen offset:1024 sc1
    buffer_load_dwordx2 v[70:71], v59, s[48:51], s69 offen offset:1536 sc1
    buffer_load_dwordx2 v[72:73], v59, s[48:51], s69 offen offset:2048 sc1
    s_waitcnt vmcnt(0)
    s_cmp_lg_u32 s66, 32768
    s_cbranch_scc1 L_gmode
    s_getreg_b32 s36, hwreg(HW_REG_XCC_ID, 0, 4)
    v_cmp_eq_u32 vcc, s38, v63
    v_cmp_eq_u32 s[72:73], s36, v62
    s_nop 0
    s_and_b64 vcc, vcc, s[72:73]
    s_cmp_eq_u64 vcc, -1
    s_cselect_b32 s37, 1, 0
    s_cmp_eq_u32 s37, 1
    s_cselect_b32 s71, 32, 3
    s_sub_u32 s71, 32768, s71
    s_cmp_eq_u32 s37, 1
    s_cbranch_scc1 L_gmode
    buffer_store_dwordx2 v[52:53], v58, s[56:59], s62 offen sc1
L_gmode:
    v_min3_u32 v60, v65, v67, v69
    v_min3_u32 v60, v60, v71, v73
    v_max3_u32 v61, v65, v67, v69
    v_max3_u32 v61, v61, v71, v73
    v_cmp_ne_u32 vcc, s38, v60
    v_cmp_ne_u32 s[72:73], s38, v61
    s_sub_u32 s66, s66, 1
    s_cbranch_scc1 L_exit
    s_cmp_gt_u32 s66, s71
    s_cbranch_scc1 L_gspin_k
    s_add_u32 s69, s69, s68
    s_sub_u32 s68, 0, s68
L_gspin_k:
    s_or_b64 vcc, vcc, s[72:73]
    s_cbranch_vccnz L_gspin
    v_add_f32 v52, v64, v66
    v_add_f32 v52, v52, v68
    v_add_f32 v52, v52, v70
    v_add_f32 v52, v52, v72
    v_cvt_pk_bf16_f32 v52, v52, v52
    v_lshlrev_b32 v52, 16, v52
    v_mov_b32 v53, v52
    v_lshlrev_b32 v3, 2, v3
    s_nop 0
    v_permlane32_swap_b32 v52, v53
    s_nop 1
    v_cmp_gt_f32 vcc, v52, 0
    s_nop 1
    v_cndmask_b32 v55, 0, 1.0, vcc
    v_mul_f32 v54, v52, v55
    v_mul_f32 v54, v54, v53
    v_cvt_pk_bf16_f32 v54, v54, v54
    ds_write_b32 v3, v54 offset:7040
    s_branch L_bar1
L_w3_skip:
    s_waitcnt lgkmcnt(0)
    s_barrier
    s_mov_b32 s48, s30
    s_mov_b32 s49, s31
    s_mov_b32 s50, 4194304
    s_mov_b32 s51, 0x20000
L_bar1:
    s_waitcnt lgkmcnt(0)
    s_barrier
    s_barrier
    s_cmp_ge_u32 s2, 240
    s_cbranch_scc1 L_exit
    s_lshl_b32 s6, s33, 5
    s_lshl_b32 s7, s3, 3
    s_add_u32 s6, s6, s7
    s_mul_i32 s67, s6, 1280
    s_lshl_b32 s7, s35, 8
    s_add_u32 s67, s67, s7
    s_add_u32 s40, s24, s67
    s_addc_u32 s41, s25, 0
    s_mov_b32 s42, 9216
    s_mov_b32 s43, 0x20000
    s_lshl_b32 s6, s6, 2
    s_mul_i32 s67, s6, 1280
    s_add_u32 s67, s67, s7
    s_add_u32 s44, s16, s67
    s_addc_u32 s45, s17, 0
    s_mov_b32 s46, 39936
    s_mov_b32 s47, 0x20000
    v_lshrrev_b32 v9, 4, v0
    v_and_b32 v3, 15, v0
    v_lshlrev_b32 v3, 4, v3
    v_mul_u32_u24 v8, 2560, v9
    v_add_u32 v8, v8, v3
    v_mul_u32_u24 v10, 10240, v9
    v_add_u32 v10, v10, v3
    s_movk_i32 s61, 5120
    buffer_load_dwordx4 v[96:99], v8, s[40:43], 0 offen offset:0 nt
    buffer_load_dwordx4 v[100:103], v8, s[40:43], 0 offen offset:1280 nt
    buffer_load_dwordx4 v[64:67], v10, s[44:47], 0 offen offset:0 nt
    buffer_load_dwordx4 v[68:71], v10, s[44:47], 0 offen offset:1280 nt
    buffer_load_dwordx4 v[72:75], v10, s[44:47], 0 offen offset:2560 nt
    buffer_load_dwordx4 v[76:79], v10, s[44:47], 0 offen offset:3840 nt
    buffer_load_dwordx4 v[80:83], v10, s[44:47], s61 offen offset:0 nt
    buffer_load_dwordx4 v[84:87], v10, s[44:47], s61 offen offset:1280 nt
    buffer_load_dwordx4 v[88:91], v10, s[44:47], s61 offen offset:2560 nt
    buffer_load_dwordx4 v[92:95], v10, s[44:47], s61 offen offset:3840 nt
    s_barrier
    s_lshl_b32 s6, s3, 5
    v_lshl_add_u32 v11, v9, 3, s6
    v_mov_b32 v41, 13376
    ds_read_b32 v41, v41
    ds_read_b64 v[42:43], v11 offset:7040
    v_and_b32 v3, 15, v0
    v_lshlrev_b32 v3, 5, v3
    v_bfe_u32 v13, v0, 4, 1
    v_lshl_add_u32 v13, v13, 4, v3
    s_lshl_b32 s6, s3, 10
    v_add_u32 v13, s6, v13
    s_lshr_b32 s6, s3, 1
    s_lshl_b32 s7, s33, 1
    s_add_u32 s6, s6, s7
    s_mul_i32 s67, s6, 171
    s_lshr_b32 s67, s67, 9
    s_mul_i32 s68, s67, 3
    s_sub_u32 s68, s6, s68
    s_mul_i32 s69, s67, 24
    s_add_u32 s69, s69, s68
    s_lshl_b32 s69, s69, 9
    s_and_b32 s6, s3, 1
    s_lshl_b32 s6, s6, 8
    s_add_u32 s69, s69, s6
    s_add_u32 s69, s69, 524288
    s_add_u32 s70, s69, 6144
    s_lshl_b32 s67, s67, 7
    s_add_u32 s67, s67, 983040
    v_bfe_u32 v16, v0, 3, 1
    v_mul_u32_u24 v16, 1536, v16
    v_lshl_add_u32 v16, v9, 6, v16
    v_lshl_add_u32 v16, v2, 3, v16
    v_lshlrev_b32 v17, 4, v2
    v_mov_b32 v18, 0x3fb8aa3b
    s_waitcnt lgkmcnt(0)
    v_readfirstlane_b32 s37, v41
    v_and_b32 v160, v42, v4
    v_and_b32 v161, v42, v5
    v_and_b32 v162, v42, v6
    v_and_b32 v163, v42, v7
    v_and_b32 v164, v43, v4
    v_and_b32 v165, v43, v5
    v_and_b32 v166, v43, v6
    v_and_b32 v167, v43, v7
    s_waitcnt vmcnt(9)
    v_mfma_f32_16x16x32_bf16 v[196:199], v[160:163], v[96:99], 0
    s_waitcnt vmcnt(8)
    v_mfma_f32_16x16x32_bf16 v[196:199], v[164:167], v[100:103], v[196:199]
    s_mov_b32 s64, -1
    s_mov_b32 s65, 0
    s_nop 5
    s_mov_b64 exec, s[64:65]
    ds_write_b128 v13, v[196:199] offset:14400
    s_mov_b64 exec, -1
    s_waitcnt vmcnt(3)
    s_mov_b32 s68, 0x280000
    s_cmp_eq_u32 s37, 1
    s_cselect_b32 s71, 32, 3
    s_sub_u32 s71, 32768, s71
    s_mov_b32 s66, 32768
L_ospin:
    buffer_load_dwordx4 v[112:115], v17, s[48:51], s67 offen sc1
    buffer_load_dwordx2 v[104:105], v16, s[48:51], s69 offen offset:0 sc1
    buffer_load_dwordx2 v[106:107], v16, s[48:51], s69 offen offset:3072 sc1
    buffer_load_dwordx2 v[108:109], v16, s[48:51], s70 offen offset:0 sc1
    buffer_load_dwordx2 v[110:111], v16, s[48:51], s70 offen offset:3072 sc1
    s_waitcnt vmcnt(0)
    v_min3_u32 v54, v115, v105, v107
    v_min3_u32 v54, v54, v109, v111
    v_max3_u32 v55, v115, v105, v107
    v_max3_u32 v55, v55, v109, v111
    v_cmp_ne_u32 vcc, s38, v54
    v_cmp_ne_u32 s[72:73], s38, v55
    s_sub_u32 s66, s66, 1
    s_cbranch_scc1 L_exit
    s_cmp_gt_u32 s66, s71
    s_cbranch_scc1 L_ospin_k
    s_add_u32 s67, s67, s68
    s_add_u32 s69, s69, s68
    s_add_u32 s70, s70, s68
    s_sub_u32 s68, 0, s68
L_ospin_k:
    s_or_b64 vcc, vcc, s[72:73]
    s_cbranch_vccnz L_ospin
    v_mov_b32 v40, v112
    s_nop 1
    v_max_f32_dpp v40, v40, v40 quad_perm:[1,0,3,2] row_mask:0xf bank_mask:0xf
    s_nop 1
    v_max_f32_dpp v40, v40, v40 quad_perm:[2,3,0,1] row_mask:0xf bank_mask:0xf
    s_nop 1
    v_max_f32_dpp v40, v40, v40 row_half_mirror row_mask:0xf bank_mask:0xf
    v_sub_f32 v40, v112, v40
    v_mul_f32 v40, v40, v18
    v_exp_f32 v40, v40
    s_nop 0
    v_mul_f32 v41, v40, v113
    s_nop 1
    v_add_f32_dpp v41, v41, v41 quad_perm:[1,0,3,2] row_mask:0xf bank_mask:0xf
    s_nop 1
    v_add_f32_dpp v41, v41, v41 quad_perm:[2,3,0,1] row_mask:0xf bank_mask:0xf
    s_nop 1
    v_add_f32_dpp v41, v41, v41 row_half_mirror row_mask:0xf bank_mask:0xf
    v_rcp_f32 v42, v41
    s_nop 0
    v_mul_f32 v43, v40, v42
    v_fma_f32 v44, -v43, v41, v40
    v_fmac_f32 v43, v44, v42
    s_nop 1
    v_mul_f32_dpp v44, v43, v104 row_newbcast:0 row_mask:0xf bank_mask:0x3
    v_mul_f32_dpp v44, v43, v104 row_newbcast:1 row_mask:0xf bank_mask:0xc
    v_fmac_f32_dpp v44, v43, v106 row_newbcast:2 row_mask:0xf bank_mask:0x3
    v_fmac_f32_dpp v44, v43, v106 row_newbcast:3 row_mask:0xf bank_mask:0xc
    v_fmac_f32_dpp v44, v43, v108 row_newbcast:4 row_mask:0xf bank_mask:0x3
    v_fmac_f32_dpp v44, v43, v108 row_newbcast:5 row_mask:0xf bank_mask:0xc
    v_fmac_f32_dpp v44, v43, v110 row_newbcast:6 row_mask:0xf bank_mask:0x3
    v_fmac_f32_dpp v44, v43, v110 row_newbcast:7 row_mask:0xf bank_mask:0xc
    s_nop 1
    v_add_f32_dpp v44, v44, v44 row_ror:8 row_mask:0xf bank_mask:0xf
    v_cvt_pk_bf16_f32 v44, v44, v44
    s_nop 1
    v_and_b32_dpp v128, v44, v4 row_newbcast:0 row_mask:0xf bank_mask:0xf
    v_and_b32_dpp v129, v44, v5 row_newbcast:0 row_mask:0xf bank_mask:0xf
    v_and_b32_dpp v130, v44, v6 row_newbcast:0 row_mask:0xf bank_mask:0xf
    v_and_b32_dpp v131, v44, v7 row_newbcast:0 row_mask:0xf bank_mask:0xf
    v_and_b32_dpp v132, v44, v4 row_newbcast:1 row_mask:0xf bank_mask:0xf
    v_and_b32_dpp v133, v44, v5 row_newbcast:1 row_mask:0xf bank_mask:0xf
    v_and_b32_dpp v134, v44, v6 row_newbcast:1 row_mask:0xf bank_mask:0xf
    v_and_b32_dpp v135, v44, v7 row_newbcast:1 row_mask:0xf bank_mask:0xf
    v_mfma_f32_16x16x32_bf16 v[192:195], v[128:131], v[64:67], 0
    v_and_b32_dpp v136, v44, v4 row_newbcast:2 row_mask:0xf bank_mask:0xf
    v_and_b32_dpp v137, v44, v5 row_newbcast:2 row_mask:0xf bank_mask:0xf
    v_and_b32_dpp v138, v44, v6 row_newbcast:2 row_mask:0xf bank_mask:0xf
    v_and_b32_dpp v139, v44, v7 row_newbcast:2 row_mask:0xf bank_mask:0xf
    v_mfma_f32_16x16x32_bf16 v[192:195], v[132:135], v[68:71], v[192:195]
    v_and_b32_dpp v140, v44, v4 row_newbcast:3 row_mask:0xf bank_mask:0xf
    v_and_b32_dpp v141, v44, v5 row_newbcast:3 row_mask:0xf bank_mask:0xf
    v_and_b32_dpp v142, v44, v6 row_newbcast:3 row_mask:0xf bank_mask:0xf
    v_and_b32_dpp v143, v44, v7 row_newbcast:3 row_mask:0xf bank_mask:0xf
    v_mfma_f32_16x16x32_bf16 v[192:195], v[136:139], v[72:75], v[192:195]
    v_and_b32_dpp v144, v44, v4 row_newbcast:4 row_mask:0xf bank_mask:0xf
    v_and_b32_dpp v145, v44, v5 row_newbcast:4 row_mask:0xf bank_mask:0xf
    v_and_b32_dpp v146, v44, v6 row_newbcast:4 row_mask:0xf bank_mask:0xf
    v_and_b32_dpp v147, v44, v7 row_newbcast:4 row_mask:0xf bank_mask:0xf
    v_mfma_f32_16x16x32_bf16 v[192:195], v[140:143], v[76:79], v[192:195]
    v_and_b32_dpp v148, v44, v4 row_newbcast:5 row_mask:0xf bank_mask:0xf
    v_and_b32_dpp v149, v44, v5 row_newbcast:5 row_mask:0xf bank_mask:0xf
    v_and_b32_dpp v150, v44, v6 row_newbcast:5 row_mask:0xf bank_mask:0xf
    v_and_b32_dpp v151, v44, v7 row_newbcast:5 row_mask:0xf bank_mask:0xf
    v_mfma_f32_16x16x32_bf16 v[192:195], v[144:147], v[80:83], v[192:195]
    v_and_b32_dpp v152, v44, v4 row_newbcast:6 row_mask:0xf bank_mask:0xf
    v_and_b32_dpp v153, v44, v5 row_newbcast:6 row_mask:0xf bank_mask:0xf
    v_and_b32_dpp v154, v44, v6 row_newbcast:6 row_mask:0xf bank_mask:0xf
    v_and_b32_dpp v155, v44, v7 row_newbcast:6 row_mask:0xf bank_mask:0xf
    v_mfma_f32_16x16x32_bf16 v[192:195], v[148:151], v[84:87], v[192:195]
    v_and_b32_dpp v156, v44, v4 row_newbcast:7 row_mask:0xf bank_mask:0xf
    v_and_b32_dpp v157, v44, v5 row_newbcast:7 row_mask:0xf bank_mask:0xf
    v_and_b32_dpp v158, v44, v6 row_newbcast:7 row_mask:0xf bank_mask:0xf
    v_and_b32_dpp v159, v44, v7 row_newbcast:7 row_mask:0xf bank_mask:0xf
    v_mfma_f32_16x16x32_bf16 v[192:195], v[152:155], v[88:91], v[192:195]
    s_nop 1
    v_mfma_f32_16x16x32_bf16 v[192:195], v[156:159], v[92:95], v[192:195]
    s_nop 6
    s_mov_b64 exec, s[64:65]
    ds_write_b128 v13, v[192:195] offset:13888
    s_mov_b64 exec, -1
    s_waitcnt lgkmcnt(0)
    s_barrier
    s_cmp_ge_u32 s3, 2
    s_cbranch_scc1 L_exit
    s_lshl_b32 s6, s3, 8
    v_lshl_add_u32 v3, v0, 2, s6
    v_add_u32 v3, 13888, v3
    ds_read2st64_b32 v[52:53], v3 offset0:0 offset1:4
    ds_read2st64_b32 v[54:55], v3 offset0:8 offset1:12
    ds_read2st64_b32 v[56:57], v3 offset0:2 offset1:6
    ds_read2st64_b32 v[58:59], v3 offset0:10 offset1:14
    s_mul_i32 s6, s35, 48
    s_add_u32 s6, s6, s33
    s_lshl_b32 s6, s6, 11
    s_lshl_b32 s7, s3, 10
    s_add_u32 s6, s6, s7
    s_add_u32 s6, s6, 1048576
    v_lshlrev_b32 v9, 4, v0
    s_waitcnt lgkmcnt(0)
    v_add_f32 v52, v52, v53
    v_add_f32 v54, v54, v55
    v_add_f32 v56, v56, v57
    v_add_f32 v58, v58, v59
    v_add_f32 v52, v52, v54
    v_add_f32 v53, v56, v58
    v_mov_b32 v54, 0
    v_mov_b32 v55, s38
    buffer_store_dwordx4 v[52:55], v9, s[48:51], s6 offen sc1
    s_cmp_eq_u32 s3, 0
    s_cbranch_scc0 L_exit
    s_cmp_ge_u32 s2, 80
    s_cbranch_scc1 L_exit
    s_lshr_b32 s6, s2, 4
    s_and_b32 s7, s2, 15
    s_lshl_b32 s67, s2, 4
    s_add_u32 s52, s8, s67
    s_addc_u32 s53, s9, 0
    s_mov_b32 s54, 16
    s_mov_b32 s55, 0x20000
    s_add_u32 s56, s26, s67
    s_addc_u32 s57, s27, 0
    s_mov_b32 s58, 16
    s_mov_b32 s59, 0x20000
    v_lshlrev_b32 v10, 1, v2
    buffer_load_ushort v11, v10, s[52:55], 0 offen
    s_mul_i32 s69, s6, 98304
    s_lshl_b32 s7, s7, 7
    s_add_u32 s69, s69, s7
    s_add_u32 s69, s69, 1048576
    v_lshlrev_b32 v9, 11, v1
    v_lshl_add_u32 v9, v2, 4, v9
    s_mov_b32 s70, 16384
    v_mov_b32 v241, 0x3fb8aa3b
    s_waitcnt vmcnt(0)
    s_mov_b32 s66, 32768
L_fspin:
    s_mov_b32 s71, s69
    buffer_load_dwordx4 v[64:67], v9, s[48:51], s71 offen sc1
    s_add_u32 s71, s71, s70
    buffer_load_dwordx4 v[68:71], v9, s[48:51], s71 offen sc1
    s_add_u32 s71, s71, s70
    buffer_load_dwordx4 v[72:75], v9, s[48:51], s71 offen sc1
    s_add_u32 s71, s71, s70
    buffer_load_dwordx4 v[76:79], v9, s[48:51], s71 offen sc1
    s_add_u32 s71, s71, s70
    buffer_load_dwordx4 v[80:83], v9, s[48:51], s71 offen sc1
    s_add_u32 s71, s71, s70
    buffer_load_dwordx4 v[84:87], v9, s[48:51], s71 offen sc1
    s_waitcnt vmcnt(0)
    v_min3_u32 v54, v67, v71, v75
    v_min3_u32 v54, v54, v79, v83
    v_min_u32 v54, v54, v87
    v_max3_u32 v55, v67, v71, v75
    v_max3_u32 v55, v55, v79, v83
    v_max_u32 v55, v55, v87
    v_cmp_ne_u32 vcc, s38, v54
    v_cmp_ne_u32 s[72:73], s38, v55
    s_sub_u32 s66, s66, 1
    s_cbranch_scc1 L_exit
    s_or_b64 vcc, vcc, s[72:73]
    s_cbranch_vccnz L_fspin
    v_add_f32 v52, v64, v68
    v_add_f32 v53, v65, v69
    v_add_f32 v54, v72, v76
    v_add_f32 v55, v73, v77
    v_add_f32 v56, v80, v84
    v_add_f32 v57, v81, v85
    v_add_f32 v52, v52, v54
    v_add_f32 v53, v53, v55
    v_add_f32 v52, v52, v56
    v_add_f32 v53, v53, v57
    s_nop 0
    v_add_f32_dpp v52, v52, v52 row_ror:8 row_mask:0xf bank_mask:0xf
    v_add_f32_dpp v53, v53, v53 row_ror:8 row_mask:0xf bank_mask:0xf
    v_mov_b32 v54, v52
    v_mov_b32 v55, v53
    s_nop 1
    v_permlane16_swap_b32 v52, v54
    v_permlane16_swap_b32 v53, v55
    s_nop 1
    v_add_f32 v52, v52, v54
    v_add_f32 v53, v53, v55
    v_mov_b32 v54, v52
    v_mov_b32 v55, v53
    s_nop 1
    v_permlane32_swap_b32 v52, v54
    v_permlane32_swap_b32 v53, v55
    s_nop 1
    v_add_f32 v52, v52, v54
    v_add_f32 v53, v53, v55
    v_cvt_pk_bf16_f32 v52, v52, v53
    v_lshlrev_b32 v54, 16, v52
    v_and_b32 v53, s60, v52
    v_mul_f32 v55, v53, v241
    v_exp_f32 v55, -v55
    s_nop 0
    v_add_f32 v55, 1.0, v55
    v_rcp_f32 v56, v55
    s_nop 0
    v_mul_f32 v57, v53, v56
    v_fma_f32 v58, -v57, v55, v53
    v_fmac_f32 v57, v58, v56
    v_cvt_pk_bf16_f32 v57, v57, v57
    v_lshlrev_b32 v57, 16, v57
    v_mul_f32 v54, v54, v57
    v_cvt_pk_bf16_f32 v54, v54, v54
    v_lshlrev_b32 v54, 16, v54
    v_lshlrev_b32 v11, 16, v11
    v_add_f32 v54, v11, v54
    v_cvt_pk_bf16_f32 v54, v54, v54
    s_add_u32 s39, s39, 1
    v_mov_b32 v12, s39
    v_mov_b32 v13, 0
    s_mov_b64 exec, 0xff
    buffer_store_short v54, v10, s[56:59], 0 offen
    s_cmp_eq_u32 s2, 0
    s_cbranch_scc0 L_exit
    s_mov_b64 exec, 1
    buffer_store_dword v12, v13, s[48:51], 0 offen sc1
    s_branch L_exit
L_kv:
    s_sub_u32 s7, s3, 4
    s_mul_i32 s6, s4, 3145728
    s_lshl_b32 s67, s5, 2
    s_add_u32 s67, s67, s7
    s_mul_i32 s67, s67, 24576
    s_add_u32 s6, s6, s67
    s_add_u32 s6, s6, 2359296
    v_mul_u32_u24 v8, 384, v1
    v_lshl_add_u32 v8, v2, 4, v8
    s_movk_i32 s61, 6144
    s_movk_i32 s62, 12288
    s_movk_i32 s63, 18432
    s_waitcnt lgkmcnt(0)
    s_load_dword s39, s[30:31], 0
    s_add_u32 s40, s10, s6
    s_addc_u32 s41, s11, 0
    s_mov_b32 s42, 24576
    s_mov_b32 s43, 0x20000
    s_add_u32 s44, s12, s6
    s_addc_u32 s45, s13, 0
    s_mov_b32 s46, 24576
    s_mov_b32 s47, 0x20000
    s_mov_b32 s48, s30
    s_mov_b32 s49, s31
    s_mov_b32 s50, 4194304
    s_mov_b32 s51, 0x20000
    s_cmp_eq_u32 s3, 4
    s_cbranch_scc0 L_nopres
    s_waitcnt lgkmcnt(0)
    s_mul_i32 s38, s39, 0x9e3779b1
    s_xor_b32 s38, s38, 0x7f4a7c15
    s_mov_b32 s67, s7
    s_and_b32 s6, s2, 7
    s_lshl_b32 s6, s6, 8
    s_lshr_b32 s7, s2, 3
    s_lshl_b32 s7, s7, 3
    s_add_u32 s6, s6, s7
    s_add_u32 s6, s6, 1024
    s_getreg_b32 s36, hwreg(HW_REG_XCC_ID, 0, 4)
    v_mov_b32 v60, s36
    v_mov_b32 v61, s38
    v_mov_b32 v62, 0
    s_mov_b64 exec, 1
    buffer_store_dwordx2 v[60:61], v62, s[48:51], s6 offen
    s_mov_b64 exec, -1
    s_mov_b32 s7, s67
L_nopres:
    s_barrier
    buffer_load_dwordx4 v[16:19], v8, s[40:43], 0 offen offset:0 nt
    buffer_load_dwordx4 v[20:23], v8, s[40:43], 0 offen offset:128 nt
    buffer_load_dwordx4 v[24:27], v8, s[40:43], 0 offen offset:256 nt
    buffer_load_dwordx4 v[28:31], v8, s[40:43], 0 offen offset:3072 nt
    buffer_load_dwordx4 v[32:35], v8, s[40:43], 0 offen offset:3200 nt
    buffer_load_dwordx4 v[36:39], v8, s[40:43], 0 offen offset:3328 nt
    buffer_load_dwordx4 v[40:43], v8, s[40:43], s61 offen offset:0 nt
    buffer_load_dwordx4 v[44:47], v8, s[40:43], s61 offen offset:128 nt
    buffer_load_dwordx4 v[48:51], v8, s[40:43], s61 offen offset:256 nt
    buffer_load_dwordx4 v[52:55], v8, s[40:43], s61 offen offset:3072 nt
    buffer_load_dwordx4 v[56:59], v8, s[40:43], s61 offen offset:3200 nt
    buffer_load_dwordx4 v[60:63], v8, s[40:43], s61 offen offset:3328 nt
    s_waitcnt vmcnt(11)
    buffer_load_dwordx4 v[64:67], v8, s[40:43], s62 offen offset:0 nt
    s_waitcnt vmcnt(11)
    buffer_load_dwordx4 v[68:71], v8, s[40:43], s62 offen offset:128 nt
    s_waitcnt vmcnt(11)
    buffer_load_dwordx4 v[72:75], v8, s[40:43], s62 offen offset:256 nt
    s_waitcnt vmcnt(11)
    buffer_load_dwordx4 v[76:79], v8, s[40:43], s62 offen offset:3072 nt
    s_waitcnt vmcnt(11)
    buffer_load_dwordx4 v[80:83], v8, s[40:43], s62 offen offset:3200 nt
    s_waitcnt vmcnt(11)
    buffer_load_dwordx4 v[84:87], v8, s[40:43], s62 offen offset:3328 nt
    s_waitcnt vmcnt(11)
    buffer_load_dwordx4 v[88:91], v8, s[40:43], s63 offen offset:0 nt
    s_waitcnt vmcnt(11)
    buffer_load_dwordx4 v[92:95], v8, s[40:43], s63 offen offset:128 nt
    s_waitcnt vmcnt(11)
    buffer_load_dwordx4 v[96:99], v8, s[40:43], s63 offen offset:256 nt
    s_waitcnt vmcnt(11)
    buffer_load_dwordx4 v[100:103], v8, s[40:43], s63 offen offset:3072 nt
    s_waitcnt vmcnt(11)
    buffer_load_dwordx4 v[104:107], v8, s[40:43], s63 offen offset:3200 nt
    s_waitcnt vmcnt(11)
    buffer_load_dwordx4 v[108:111], v8, s[40:43], s63 offen offset:3328 nt
    s_waitcnt vmcnt(11)
    buffer_load_dwordx4 v[112:115], v8, s[44:47], 0 offen offset:0 nt
    s_waitcnt vmcnt(11)
    buffer_load_dwordx4 v[116:119], v8, s[44:47], 0 offen offset:128 nt
    s_waitcnt vmcnt(11)
    buffer_load_dwordx4 v[120:123], v8, s[44:47], 0 offen offset:256 nt
    s_waitcnt vmcnt(11)
    buffer_load_dwordx4 v[124:127], v8, s[44:47], 0 offen offset:3072 nt
    s_waitcnt vmcnt(11)
    buffer_load_dwordx4 v[128:131], v8, s[44:47], 0 offen offset:3200 nt
    s_waitcnt vmcnt(11)
    buffer_load_dwordx4 v[132:135], v8, s[44:47], 0 offen offset:3328 nt
    s_waitcnt vmcnt(11)
    buffer_load_dwordx4 v[136:139], v8, s[44:47], s61 offen offset:0 nt
    s_waitcnt vmcnt(11)
    buffer_load_dwordx4 v[140:143], v8, s[44:47], s61 offen offset:128 nt
    s_waitcnt vmcnt(11)
    buffer_load_dwordx4 v[144:147], v8, s[44:47], s61 offen offset:256 nt
    s_waitcnt vmcnt(11)
    buffer_load_dwordx4 v[148:151], v8, s[44:47], s61 offen offset:3072 nt
    s_waitcnt vmcnt(11)
    buffer_load_dwordx4 v[152:155], v8, s[44:47], s61 offen offset:3200 nt
    s_waitcnt vmcnt(11)
    buffer_load_dwordx4 v[156:159], v8, s[44:47], s61 offen offset:3328 nt
    s_waitcnt vmcnt(11)
    buffer_load_dwordx4 v[160:163], v8, s[44:47], s62 offen offset:0 nt
    s_waitcnt vmcnt(11)
    buffer_load_dwordx4 v[164:167], v8, s[44:47], s62 offen offset:128 nt
    s_mov_b32 s48, s30
    s_mov_b32 s49, s31
    s_mov_b32 s50, 4194304
    s_mov_b32 s51, 0x20000
    s_add_u32 s56, s30, 0x280000
    s_addc_u32 s57, s31, 0
    s_mov_b32 s58, 0x180000
    s_mov_b32 s59, 0x20000
    v_and_b32 v9, 3, v2
    v_lshlrev_b32 v9, 4, v9
    v_mov_b32 v4, 0xffff
    v_mov_b32 v5, 0
    v_lshlrev_b64 v[250:251], v9, v[4:5]
    v_lshrrev_b32 v9, 2, v2
    v_add_u32 v9, -1, v9
    v_and_b32 v4, v250, v9
    v_and_b32 v5, v251, v9
    v_not_b32 v9, v9
    v_and_b32 v6, v250, v9
    v_and_b32 v7, v251, v9
    v_lshlrev_b32 v3, 4, v2
    v_mov_b32 v240, 0x3d93cd3a
    v_mov_b32 v241, 0x3fb8aa3b
    s_waitcnt lgkmcnt(0)
    s_mul_i32 s38, s39, 0x9e3779b1
    s_xor_b32 s38, s38, 0x7f4a7c15
    s_barrier
    s_waitcnt vmcnt(11)
    buffer_load_dwordx4 v[168:171], v8, s[44:47], s62 offen offset:256 nt
    ds_read_b128 v[208:211], v3 offset:6656
    ds_read_b128 v[212:215], v3 offset:6784
    ds_read_b128 v[216:219], v3 offset:6912
    v_mov_b32 v242, 13376
    ds_read_b32 v242, v242
    v_mov_b32 v220, 0
    v_mov_b32 v221, 0
    v_mov_b32 v222, 0
    v_mov_b32 v223, 0
    v_mov_b32 v224, 0
    v_mov_b32 v225, 0
    v_mov_b32 v226, 0
    v_mov_b32 v227, 0
    s_waitcnt lgkmcnt(0)
    v_readfirstlane_b32 s37, v242
    v_dot2c_f32_bf16 v220, v16, v208
    v_dot2c_f32_bf16 v221, v28, v208
    v_dot2c_f32_bf16 v222, v40, v208
    v_dot2c_f32_bf16 v223, v52, v208
    v_dot2c_f32_bf16 v224, v64, v208
    v_dot2c_f32_bf16 v225, v76, v208
    v_dot2c_f32_bf16 v226, v88, v208
    v_dot2c_f32_bf16 v227, v100, v208
    v_dot2c_f32_bf16 v220, v17, v209
    v_dot2c_f32_bf16 v221, v29, v209
    v_dot2c_f32_bf16 v222, v41, v209
    v_dot2c_f32_bf16 v223, v53, v209
    s_waitcnt vmcnt(11)
    buffer_load_dwordx4 v[172:175], v8, s[44:47], s62 offen offset:3072 nt
    v_dot2c_f32_bf16 v224, v65, v209
    v_dot2c_f32_bf16 v225, v77, v209
    v_dot2c_f32_bf16 v226, v89, v209
    v_dot2c_f32_bf16 v227, v101, v209
    v_dot2c_f32_bf16 v220, v18, v210
    v_dot2c_f32_bf16 v221, v30, v210
    v_dot2c_f32_bf16 v222, v42, v210
    v_dot2c_f32_bf16 v223, v54, v210
    v_dot2c_f32_bf16 v224, v66, v210
    v_dot2c_f32_bf16 v225, v78, v210
    v_dot2c_f32_bf16 v226, v90, v210
    v_dot2c_f32_bf16 v227, v102, v210
    v_dot2c_f32_bf16 v220, v19, v211
    v_dot2c_f32_bf16 v221, v31, v211
    v_dot2c_f32_bf16 v222, v43, v211
    v_dot2c_f32_bf16 v223, v55, v211
    v_dot2c_f32_bf16 v224, v67, v211
    v_dot2c_f32_bf16 v225, v79, v211
    v_dot2c_f32_bf16 v226, v91, v211
    v_dot2c_f32_bf16 v227, v103, v211
    v_dot2c_f32_bf16 v220, v20, v212
    v_dot2c_f32_bf16 v221, v32, v212
    v_dot2c_f32_bf16 v222, v44, v212
    v_dot2c_f32_bf16 v223, v56, v212
    v_dot2c_f32_bf16 v224, v68, v212
    v_dot2c_f32_bf16 v225, v80, v212
    v_dot2c_f32_bf16 v226, v92, v212
    s_waitcnt vmcnt(11)
    buffer_load_dwordx4 v[176:179], v8, s[44:47], s62 offen offset:3200 nt
    v_dot2c_f32_bf16 v227, v104, v212
    v_dot2c_f32_bf16 v220, v21, v213
    v_dot2c_f32_bf16 v221, v33, v213
    v_dot2c_f32_bf16 v222, v45, v213
    v_dot2c_f32_bf16 v223, v57, v213
    v_dot2c_f32_bf16 v224, v69, v213
    v_dot2c_f32_bf16 v225, v81, v213
    v_dot2c_f32_bf16 v226, v93, v213
    v_dot2c_f32_bf16 v227, v105, v213
    v_dot2c_f32_bf16 v220, v22, v214
    v_dot2c_f32_bf16 v221, v34, v214
    v_dot2c_f32_bf16 v222, v46, v214
    v_dot2c_f32_bf16 v223, v58, v214
    v_dot2c_f32_bf16 v224, v70, v214
    v_dot2c_f32_bf16 v225, v82, v214
    v_dot2c_f32_bf16 v226, v94, v214
    v_dot2c_f32_bf16 v227, v106, v214
    v_dot2c_f32_bf16 v220, v23, v215
    v_dot2c_f32_bf16 v221, v35, v215
    v_dot2c_f32_bf16 v222, v47, v215
    v_dot2c_f32_bf16 v223, v59, v215
    v_dot2c_f32_bf16 v224, v71, v215
    v_dot2c_f32_bf16 v225, v83, v215
    v_dot2c_f32_bf16 v226, v95, v215
    v_dot2c_f32_bf16 v227, v107, v215
    v_dot2c_f32_bf16 v220, v24, v216
    v_dot2c_f32_bf16 v221, v36, v216
    s_waitcnt vmcnt(11)
    buffer_load_dwordx4 v[180:183], v8, s[44:47], s62 offen offset:3328 nt
    v_dot2c_f32_bf16 v222, v48, v216
    v_dot2c_f32_bf16 v223, v60, v216
    v_dot2c_f32_bf16 v224, v72, v216
    v_dot2c_f32_bf16 v225, v84, v216
    v_dot2c_f32_bf16 v226, v96, v216
    v_dot2c_f32_bf16 v227, v108, v216
    v_dot2c_f32_bf16 v220, v25, v217
    v_dot2c_f32_bf16 v221, v37, v217
    v_dot2c_f32_bf16 v222, v49, v217
    v_dot2c_f32_bf16 v223, v61, v217
    v_dot2c_f32_bf16 v224, v73, v217
    v_dot2c_f32_bf16 v225, v85, v217
    v_dot2c_f32_bf16 v226, v97, v217
    v_dot2c_f32_bf16 v227, v109, v217
    v_dot2c_f32_bf16 v220, v26, v218
    v_dot2c_f32_bf16 v221, v38, v218
    v_dot2c_f32_bf16 v222, v50, v218
    v_dot2c_f32_bf16 v223, v62, v218
    v_dot2c_f32_bf16 v224, v74, v218
    v_dot2c_f32_bf16 v225, v86, v218
    v_dot2c_f32_bf16 v226, v98, v218
    v_dot2c_f32_bf16 v227, v110, v218
    v_dot2c_f32_bf16 v220, v27, v219
    v_dot2c_f32_bf16 v221, v39, v219
    v_dot2c_f32_bf16 v222, v51, v219
    v_dot2c_f32_bf16 v223, v63, v219
    v_dot2c_f32_bf16 v224, v75, v219
    s_waitcnt vmcnt(11)
    buffer_load_dwordx4 v[184:187], v8, s[44:47], s63 offen offset:0 nt
    v_dot2c_f32_bf16 v225, v87, v219
    v_dot2c_f32_bf16 v226, v99, v219
    v_dot2c_f32_bf16 v227, v111, v219
    v_add_f32_dpp v220, v220, v220 quad_perm:[1,0,3,2] row_mask:0xf bank_mask:0xf
    v_add_f32_dpp v221, v221, v221 quad_perm:[1,0,3,2] row_mask:0xf bank_mask:0xf
    v_add_f32_dpp v222, v222, v222 quad_perm:[1,0,3,2] row_mask:0xf bank_mask:0xf
    v_add_f32_dpp v223, v223, v223 quad_perm:[1,0,3,2] row_mask:0xf bank_mask:0xf
    v_add_f32_dpp v224, v224, v224 quad_perm:[1,0,3,2] row_mask:0xf bank_mask:0xf
    v_add_f32_dpp v225, v225, v225 quad_perm:[1,0,3,2] row_mask:0xf bank_mask:0xf
    v_add_f32_dpp v226, v226, v226 quad_perm:[1,0,3,2] row_mask:0xf bank_mask:0xf
    v_add_f32_dpp v227, v227, v227 quad_perm:[1,0,3,2] row_mask:0xf bank_mask:0xf
    v_add_f32_dpp v220, v220, v220 quad_perm:[2,3,0,1] row_mask:0xf bank_mask:0xf
    v_add_f32_dpp v221, v221, v221 quad_perm:[2,3,0,1] row_mask:0xf bank_mask:0xf
    v_add_f32_dpp v222, v222, v222 quad_perm:[2,3,0,1] row_mask:0xf bank_mask:0xf
    v_add_f32_dpp v223, v223, v223 quad_perm:[2,3,0,1] row_mask:0xf bank_mask:0xf
    v_add_f32_dpp v224, v224, v224 quad_perm:[2,3,0,1] row_mask:0xf bank_mask:0xf
    v_add_f32_dpp v225, v225, v225 quad_perm:[2,3,0,1] row_mask:0xf bank_mask:0xf
    v_add_f32_dpp v226, v226, v226 quad_perm:[2,3,0,1] row_mask:0xf bank_mask:0xf
    v_add_f32_dpp v227, v227, v227 quad_perm:[2,3,0,1] row_mask:0xf bank_mask:0xf
    v_add_f32_dpp v220, v220, v220 row_half_mirror row_mask:0xf bank_mask:0xf
    v_add_f32_dpp v221, v221, v221 row_half_mirror row_mask:0xf bank_mask:0xf
    v_add_f32_dpp v222, v222, v222 row_half_mirror row_mask:0xf bank_mask:0xf
    v_add_f32_dpp v223, v223, v223 row_half_mirror row_mask:0xf bank_mask:0xf
    v_add_f32_dpp v224, v224, v224 row_half_mirror row_mask:0xf bank_mask:0xf
    v_add_f32_dpp v225, v225, v225 row_half_mirror row_mask:0xf bank_mask:0xf
    v_add_f32_dpp v226, v226, v226 row_half_mirror row_mask:0xf bank_mask:0xf
    v_add_f32_dpp v227, v227, v227 row_half_mirror row_mask:0xf bank_mask:0xf
    s_waitcnt vmcnt(11)
    buffer_load_dwordx4 v[188:191], v8, s[44:47], s63 offen offset:128 nt
    v_cvt_pk_bf16_f32 v242, v220, v221
    v_cvt_pk_bf16_f32 v243, v222, v223
    v_cvt_pk_bf16_f32 v244, v224, v225
    v_cvt_pk_bf16_f32 v245, v226, v227
    v_lshlrev_b32 v220, 16, v242
    v_and_b32 v221, s60, v242
    v_lshlrev_b32 v222, 16, v243
    v_and_b32 v223, s60, v243
    v_lshlrev_b32 v224, 16, v244
    v_and_b32 v225, s60, v244
    v_lshlrev_b32 v226, 16, v245
    v_and_b32 v227, s60, v245
    v_mul_f32 v220, v220, v240
    v_mul_f32 v221, v221, v240
    v_mul_f32 v222, v222, v240
    v_mul_f32 v223, v223, v240
    v_mul_f32 v224, v224, v240
    v_mul_f32 v225, v225, v240
    v_mul_f32 v226, v226, v240
    v_mul_f32 v227, v227, v240
    v_cvt_pk_bf16_f32 v242, v220, v221
    v_cvt_pk_bf16_f32 v243, v222, v223
    v_cvt_pk_bf16_f32 v244, v224, v225
    v_cvt_pk_bf16_f32 v245, v226, v227
    v_lshlrev_b32 v220, 16, v242
    v_and_b32 v221, s60, v242
    s_waitcnt vmcnt(11)
    buffer_load_dwordx4 v[192:195], v8, s[44:47], s63 offen offset:256 nt
    v_lshlrev_b32 v222, 16, v243
    v_and_b32 v223, s60, v243
    v_lshlrev_b32 v224, 16, v244
    v_and_b32 v225, s60, v244
    v_lshlrev_b32 v226, 16, v245
    v_and_b32 v227, s60, v245
    v_max3_f32 v246, v220, v221, v222
    v_max3_f32 v247, v223, v224, v225
    v_max3_f32 v246, v246, v226, v227
    v_max_f32 v246, v246, v247
    s_nop 1
    v_max_f32_dpp v246, v246, v246 row_ror:8 row_mask:0xf bank_mask:0xf
    s_nop 1
    v_max_f32_dpp v246, v246, v246 row_bcast:15 row_mask:0xa bank_mask:0xf
    s_nop 1
    v_max_f32_dpp v246, v246, v246 row_bcast:31 row_mask:0xc bank_mask:0xf
    s_nop 0
    v_readlane_b32 s67, v246, 63
    s_nop 1
    v_subrev_f32 v220, s67, v220
    v_subrev_f32 v221, s67, v221
    v_subrev_f32 v222, s67, v222
    v_subrev_f32 v223, s67, v223
    v_subrev_f32 v224, s67, v224
    v_subrev_f32 v225, s67, v225
    v_subrev_f32 v226, s67, v226
    s_waitcnt vmcnt(11)
    buffer_load_dwordx4 v[196:199], v8, s[44:47], s63 offen offset:3072 nt
    v_subrev_f32 v227, s67, v227
    v_mul_f32 v220, v220, v241
    v_mul_f32 v221, v221, v241
    v_mul_f32 v222, v222, v241
    v_mul_f32 v223, v223, v241
    v_mul_f32 v224, v224, v241
    v_mul_f32 v225, v225, v241
    v_mul_f32 v226, v226, v241
    v_mul_f32 v227, v227, v241
    v_exp_f32 v220, v220
    v_exp_f32 v221, v221
    v_exp_f32 v222, v222
    v_exp_f32 v223, v223
    v_exp_f32 v224, v224
    v_exp_f32 v225, v225
    v_exp_f32 v226, v226
    v_exp_f32 v227, v227
    s_nop 0
    v_add_f32 v246, v220, v221
    v_add_f32 v247, v222, v223
    v_add_f32 v248, v224, v225
    v_add_f32 v249, v226, v227
    v_cvt_pk_bf16_f32 v220, v220, v220
    v_cvt_pk_bf16_f32 v221, v221, v221
    v_cvt_pk_bf16_f32 v222, v222, v222
    v_cvt_pk_bf16_f32 v223, v223, v223
    v_cvt_pk_bf16_f32 v224, v224, v224
    s_waitcnt vmcnt(11)
    buffer_load_dwordx4 v[200:203], v8, s[44:47], s63 offen offset:3200 nt
    v_cvt_pk_bf16_f32 v225, v225, v225
    v_cvt_pk_bf16_f32 v226, v226, v226
    v_cvt_pk_bf16_f32 v227, v227, v227
    v_add_f32 v246, v246, v247
    v_add_f32 v248, v248, v249
    v_add_f32 v246, v246, v248
    v_and_b32 v16, v220, v4
    v_and_b32 v17, v220, v5
    v_and_b32 v18, v220, v6
    v_and_b32 v19, v220, v7
    v_and_b32 v20, v221, v4
    v_and_b32 v21, v221, v5
    v_and_b32 v22, v221, v6
    v_and_b32 v23, v221, v7
    v_and_b32 v24, v222, v4
    v_and_b32 v25, v222, v5
    v_and_b32 v26, v222, v6
    v_and_b32 v27, v222, v7
    v_and_b32 v28, v223, v4
    v_and_b32 v29, v223, v5
    v_and_b32 v30, v223, v6
    v_and_b32 v31, v223, v7
    v_and_b32 v32, v224, v4
    v_and_b32 v33, v224, v5
    v_and_b32 v34, v224, v6
    v_and_b32 v35, v224, v7
    v_and_b32 v36, v225, v4
    s_waitcnt vmcnt(11)
    buffer_load_dwordx4 v[204:207], v8, s[44:47], s63 offen offset:3328 nt
    s_barrier
    v_and_b32 v37, v225, v5
    v_and_b32 v38, v225, v6
    v_and_b32 v39, v225, v7
    v_and_b32 v40, v226, v4
    v_and_b32 v41, v226, v5
    v_and_b32 v42, v226, v6
    v_and_b32 v43, v226, v7
    v_and_b32 v44, v227, v4
    v_and_b32 v45, v227, v5
    v_and_b32 v46, v227, v6
    v_and_b32 v47, v227, v7
    s_nop 1
    v_add_f32_dpp v246, v246, v246 row_ror:8 row_mask:0xf bank_mask:0xf
    s_nop 1
    v_add_f32_dpp v246, v246, v246 row_bcast:15 row_mask:0xa bank_mask:0xf
    s_nop 1
    v_add_f32_dpp v246, v246, v246 row_bcast:31 row_mask:0xc bank_mask:0xf
    s_nop 0
    v_readlane_b32 s68, v246, 63
    s_mul_i32 s6, s7, 1536
    s_add_u32 s6, s6, 7168
    v_lshrrev_b32 v9, 5, v0
    v_mul_u32_u24 v9, 768, v9
    v_lshl_add_u32 v9, v2, 5, v9
    v_bfe_u32 v10, v0, 4, 1
    v_lshl_add_u32 v9, v10, 4, v9
    v_add_u32 v9, s6, v9
    s_lshl_b32 s6, s7, 3
    v_mov_b32 v10, s6
    v_mov_b32 v12, s67
    v_mov_b32 v13, s68
    s_mov_b64 exec, 1
    ds_write_b64 v10, v[12:13] offset:13312
    s_mov_b64 exec, -1
    s_lshl_b32 s6, s7, 8
    s_add_u32 s6, s6, 7168
    v_lshl_add_u32 v11, v0, 2, s6
    v_mov_b32 v14, 0
    s_mul_i32 s6, s75, 3
    s_add_u32 s6, s6, s7
    s_lshl_b32 s6, s6, 9
    s_add_u32 s6, s6, 524288
    s_lshl_b32 s67, s75, 4
    s_add_u32 s67, s67, 983040
    v_lshlrev_b32 v15, 3, v0
    v_mov_b32 v55, s38
    v_mov_b32 v59, s38
    v_mov_b32 v54, 0
    s_mov_b32 s64, 0x00ff00ff
    s_mov_b32 s65, 0xff00ff00
    s_waitcnt vmcnt(23)
    v_mfma_f32_16x16x32_bf16 v[228:231], v[16:19], v[112:115], 0
    s_waitcnt vmcnt(22)
    v_mfma_f32_16x16x32_bf16 v[232:235], v[16:19], v[116:119], 0
    s_waitcnt vmcnt(21)
    v_mfma_f32_16x16x32_bf16 v[236:239], v[16:19], v[120:123], 0
    s_waitcnt vmcnt(20)
    v_mfma_f32_16x16x32_bf16 v[228:231], v[20:23], v[124:127], v[228:231]
    s_waitcnt vmcnt(19)
    v_mfma_f32_16x16x32_bf16 v[232:235], v[20:23], v[128:131], v[232:235]
    s_waitcnt vmcnt(18)
    v_mfma_f32_16x16x32_bf16 v[236:239], v[20:23], v[132:135], v[236:239]
    s_waitcnt vmcnt(17)
    v_mfma_f32_16x16x32_bf16 v[228:231], v[24:27], v[136:139], v[228:231]
    s_waitcnt vmcnt(16)
    v_mfma_f32_16x16x32_bf16 v[232:235], v[24:27], v[140:143], v[232:235]
    s_waitcnt vmcnt(15)
    v_mfma_f32_16x16x32_bf16 v[236:239], v[24:27], v[144:147], v[236:239]
    s_waitcnt vmcnt(14)
    v_mfma_f32_16x16x32_bf16 v[228:231], v[28:31], v[148:151], v[228:231]
    s_waitcnt vmcnt(13)
    v_mfma_f32_16x16x32_bf16 v[232:235], v[28:31], v[152:155], v[232:235]
    s_waitcnt vmcnt(12)
    v_mfma_f32_16x16x32_bf16 v[236:239], v[28:31], v[156:159], v[236:239]
    s_waitcnt vmcnt(11)
    v_mfma_f32_16x16x32_bf16 v[228:231], v[32:35], v[160:163], v[228:231]
    s_waitcnt vmcnt(10)
    v_mfma_f32_16x16x32_bf16 v[232:235], v[32:35], v[164:167], v[232:235]
    s_waitcnt vmcnt(9)
    v_mfma_f32_16x16x32_bf16 v[236:239], v[32:35], v[168:171], v[236:239]
    s_waitcnt vmcnt(8)
    v_mfma_f32_16x16x32_bf16 v[228:231], v[36:39], v[172:175], v[228:231]
    s_waitcnt vmcnt(7)
    v_mfma_f32_16x16x32_bf16 v[232:235], v[36:39], v[176:179], v[232:235]
    s_waitcnt vmcnt(6)
    v_mfma_f32_16x16x32_bf16 v[236:239], v[36:39], v[180:183], v[236:239]
    s_waitcnt vmcnt(5)
    v_mfma_f32_16x16x32_bf16 v[228:231], v[40:43], v[184:187], v[228:231]
    s_waitcnt vmcnt(4)
    v_mfma_f32_16x16x32_bf16 v[232:235], v[40:43], v[188:191], v[232:235]
    s_waitcnt vmcnt(3)
    v_mfma_f32_16x16x32_bf16 v[236:239], v[40:43], v[192:195], v[236:239]
    s_waitcnt vmcnt(2)
    v_mfma_f32_16x16x32_bf16 v[228:231], v[44:47], v[196:199], v[228:231]
    s_waitcnt vmcnt(1)
    v_mfma_f32_16x16x32_bf16 v[232:235], v[44:47], v[200:203], v[232:235]
    s_waitcnt vmcnt(0)
    v_mfma_f32_16x16x32_bf16 v[236:239], v[44:47], v[204:207], v[236:239]
    s_mov_b64 exec, s[64:65]
    s_nop 4
    ds_write_b128 v9, v[228:231]
    s_nop 0
    ds_write_b128 v9, v[232:235] offset:256
    s_nop 0
    ds_write_b128 v9, v[236:239] offset:512
    s_mov_b64 exec, -1
    s_waitcnt lgkmcnt(0)
    s_barrier
    s_cmp_eq_u32 s7, 3
    s_cbranch_scc1 L_exit
    ds_read_b128 v[16:19], v14 offset:13312
    ds_read_b128 v[20:23], v14 offset:13328
    ds_read2st64_b32 v[24:25], v11 offset0:0 offset1:3
    ds_read2st64_b32 v[26:27], v11 offset0:6 offset1:9
    ds_read2st64_b32 v[28:29], v11 offset0:12 offset1:15
    ds_read2st64_b32 v[30:31], v11 offset0:18 offset1:21
    s_waitcnt lgkmcnt(4)
    v_max3_f32 v52, v16, v18, v20
    v_max_f32 v52, v52, v22
    v_sub_f32 v16, v16, v52
    v_sub_f32 v18, v18, v52
    v_sub_f32 v20, v20, v52
    v_sub_f32 v22, v22, v52
    v_mul_f32 v16, v16, v241
    v_mul_f32 v18, v18, v241
    v_mul_f32 v20, v20, v241
    v_mul_f32 v22, v22, v241
    v_exp_f32 v16, v16
    v_exp_f32 v18, v18
    v_exp_f32 v20, v20
    v_exp_f32 v22, v22
    s_waitcnt lgkmcnt(0)
    v_add_f32 v24, v24, v25
    v_add_f32 v26, v26, v27
    v_add_f32 v28, v28, v29
    v_add_f32 v30, v30, v31
    v_mul_f32 v58, v16, v24
    v_mul_f32 v53, v16, v17
    v_fmac_f32 v58, v18, v26
    v_fmac_f32 v53, v18, v19
    v_fmac_f32 v58, v20, v28
    v_fmac_f32 v53, v20, v21
    v_fmac_f32 v58, v22, v30
    v_fmac_f32 v53, v22, v23
    buffer_store_dwordx2 v[58:59], v15, s[48:51], s6 offen
    s_cmp_eq_u32 s37, 1
    s_cbranch_scc1 L_nog1
    buffer_store_dwordx2 v[58:59], v15, s[56:59], s6 offen sc1
L_nog1:
    s_cmp_eq_u32 s7, 2
    s_cbranch_scc0 L_noml
    s_mov_b64 exec, 1
    buffer_store_dwordx4 v[52:55], v14, s[48:51], s67 offen
    s_cmp_eq_u32 s37, 1
    s_cbranch_scc1 L_nog2
    buffer_store_dwordx4 v[52:55], v14, s[56:59], s67 offen sc1
L_nog2:
    s_mov_b64 exec, -1
L_noml:
L_exit:
L_end:
    s_endpgm
L_codeend:
.section .rodata,"a"
.p2align 6
.amdhsa_kernel recurrent_scan__sliding_block_cached__glu_gated_reglu__decode_kernel
  .amdhsa_next_free_vgpr 256
  .amdhsa_next_free_sgpr 102
  .amdhsa_accum_offset 256
  .amdhsa_group_segment_fixed_size 0
  .amdhsa_kernarg_size 96
  .amdhsa_user_sgpr_count 2
  .amdhsa_user_sgpr_kernarg_segment_ptr 1
  .amdhsa_float_denorm_mode_32 3
  .amdhsa_system_sgpr_workgroup_id_x 1
.end_amdhsa_kernel
```
